```python
import torch

def _softmax(x, axis=-1):
    return torch.softmax(x, dim=axis)
def _gelu(x):
    return torch.nn.functional.gelu(x, approximate="tanh")
def _silu(x):
    return torch.nn.functional.silu(x)
def _sigmoid(x):
    return torch.sigmoid(x)
def _layernorm(x, axis=-1, eps=1e-5):
    m = x.mean(dim=axis, keepdim=True)
    v = x.var(dim=axis, keepdim=True, unbiased=False)
    return (x - m) / torch.sqrt(v + eps)
def _scatter_add(tgt, idx, src, axis=0):
    return tgt.clone().index_add_(axis, idx, src)
def _segment_sum(src, seg, n):
    out = torch.zeros((n,) + src.shape[1:], dtype=src.dtype)
    return out.index_add_(0, seg, src)
def _pad(x, pw):
    flat = tuple(v for pair in reversed(pw) for v in pair)
    return torch.nn.functional.pad(x, flat)

kernel_name = 'parallel_sum__sliding_block_cached__glu_gated_geglu__decode'

def setup_inputs():

    _w = (lambda a: (lambda t: t.to(torch.bfloat16) if t.is_floating_point() else t)(torch.as_tensor(a)))
    def _A_setup():
        B, Sq, D = 1, 1, 512
        Hq, Hkv, Sk, Dh = 32, 8, 65536, 128
        assert Hq % Hkv == 0, (Hq, Hkv)
        return {
            "x": _w((lambda *s: torch.randn(*s, dtype=torch.bfloat16) * 0.05)(B, Sq, D)),
            "k_cache": _w((lambda *s: torch.randn(*s, dtype=torch.bfloat16) * 1.6)(B, Hkv, Sk, Dh)),
            "v_cache": _w((lambda *s: torch.randn(*s, dtype=torch.bfloat16) * 0.8)(B, Hkv, Sk, Dh)),
            "wq": _w((lambda *s: torch.randn(*s, dtype=torch.bfloat16) * 1.6)(D, Hq * Dh) * (D ** -0.5)),
            "wo": _w((lambda *s: torch.randn(*s, dtype=torch.bfloat16) * 0.8)(Hq * Dh, D) * ((Hq * Dh) ** -0.5)),
        }
    _A_in = _A_setup()

    def _B_setup():
        B, S, Dm, Df = 1, 1, 512, 1792
        return {
            "x": _w((lambda *s: torch.randn(*s, dtype=torch.bfloat16) * 0.05)(B, S, Dm)),
            "w_gate": _w((lambda *s: torch.randn(*s, dtype=torch.bfloat16) * 0.4)(Dm, Df) * (Dm ** -0.5)),
            "w_up": _w((lambda *s: torch.randn(*s, dtype=torch.bfloat16) * 0.4)(Dm, Df) * (Dm ** -0.5)),
            "w_down": _w((lambda *s: torch.randn(*s, dtype=torch.bfloat16) * 0.4)(Df, Dm) * (Df ** -0.5)),
        }
    _B_in = _B_setup()

    return {
        "A_x": _A_in["x"],
        "A_k_cache": _A_in["k_cache"],
        "A_v_cache": _A_in["v_cache"],
        "A_wq": _A_in["wq"],
        "A_wo": _A_in["wo"],
        "B_x": _B_in["x"],
        "B_w_gate": _B_in["w_gate"],
        "B_w_up": _B_in["w_up"],
        "B_w_down": _B_in["w_down"],
    }

def reference(A_x, A_k_cache, A_v_cache, A_wq, A_wo, B_x, B_w_gate, B_w_up, B_w_down):
    def _A_ref(x, k_cache, v_cache, wq, wo):
        B, Sq, D = x.shape
        Hq, Dh = 32, 128
        Hkv, Sk = k_cache.shape[1], k_cache.shape[2]
        W = min(4096, max(256, Sk // 4))
        rep = Hq // Hkv
        q = (lambda x, *d: x.permute(*d))((x @ wq).reshape(B, Sq, Hq, Dh), 0, 2, 1, 3)
        k = (lambda x, n, axis: torch.repeat_interleave(x, n, dim=axis))(k_cache[:, :, Sk - W:, :], rep, axis=1)
        v = (lambda x, n, axis: torch.repeat_interleave(x, n, dim=axis))(v_cache[:, :, Sk - W:, :], rep, axis=1)
        scores = torch.einsum("bhqd,bhkd->bhqk", q, k) * (Dh ** -0.5)
        p = _softmax(scores, axis=-1)
        o = torch.einsum("bhqk,bhkd->bhqd", p, v)
        return (lambda x, *d: x.permute(*d))(o, 0, 2, 1, 3).reshape(B, Sq, Hq * Dh) @ wo

    def _B_ref(x, w_gate, w_up, w_down):
        g = torch.einsum("bsd,df->bsf", x, w_gate)
        u = torch.einsum("bsd,df->bsf", x, w_up)
        h = _gelu(g) * u
        return torch.einsum("bsf,fd->bsd", h, w_down)

    x = A_x
    xn = _layernorm(x, axis=-1)
    return x + _A_ref(xn, A_k_cache, A_v_cache, A_wq, A_wo) + _B_ref(xn, B_w_gate, B_w_up, B_w_down)
```

```asm
; @launch grid=(256,1,1) block=(512,1,1) lds=16384
.amdgcn_target "amdgcn-amd-amdhsa--gfx950"
.text
.globl parallel_sum__sliding_block_cached__glu_gated_geglu__decode_kernel
.p2align 8
.type parallel_sum__sliding_block_cached__glu_gated_geglu__decode_kernel,@function
parallel_sum__sliding_block_cached__glu_gated_geglu__decode_kernel:
  s_cmp_ge_u32 s2, 256
  s_cbranch_scc1 L_exit
  s_load_dwordx16 s[8:23], s[0:1], 0
  s_load_dwordx8 s[24:31], s[0:1], 64
  v_lshrrev_b32 v1, 6, v0
  v_and_b32 v0, 63, v0
  v_readfirstlane_b32 s3, v1
  s_and_b32 s4, s2, 7
  s_lshr_b32 s5, s2, 3
  s_cmp_lg_u32 s3, 0
  s_cbranch_scc1 L_notq
L_roleQ:
  s_lshr_b32 s97, s5, 3
  s_lshl_b32 s36, s97, 20
  s_lshl_b32 s98, s4, 10
  s_add_u32 s36, s36, s98
  s_and_b32 s96, s5, 7
  s_lshl_b32 s98, s96, 7
  s_add_u32 s36, s36, s98
  s_movk_i32 s37, 8192
  v_and_b32 v50, 56, v0
  v_lshlrev_b32 v50, 13, v50
  v_and_b32 v10, 7, v0
  v_lshl_add_u32 v50, v10, 4, v50
  v_lshlrev_b32 v8, 4, v0
  s_movk_i32 s46, 1024
  s_mov_b32 s47, 0x20000
  s_mov_b32 s34, 4194304
  s_mov_b32 s35, s47
  s_mov_b32 s96, 466944
  s_waitcnt lgkmcnt(0)
  s_mov_b32 s44, s8
  s_and_b32 s45, s9, 0xffff
  buffer_load_dwordx4 v[4:7], v8, s[44:47], 0 offen
  s_mov_b32 s32, s14
  s_and_b32 s33, s15, 0xffff
  buffer_load_dwordx4 v[64:67], v50, s[32:35], s36 offen nt
  s_add_u32 s36, s36, s37
  buffer_load_dwordx4 v[68:71], v50, s[32:35], s36 offen nt
  s_add_u32 s36, s36, s37
  buffer_load_dwordx4 v[72:75], v50, s[32:35], s36 offen nt
  s_add_u32 s36, s36, s37
  buffer_load_dwordx4 v[76:79], v50, s[32:35], s36 offen nt
  s_add_u32 s36, s36, s37
  buffer_load_dwordx4 v[80:83], v50, s[32:35], s36 offen nt
  s_add_u32 s36, s36, s37
  buffer_load_dwordx4 v[84:87], v50, s[32:35], s36 offen nt
  s_add_u32 s36, s36, s37
  buffer_load_dwordx4 v[88:91], v50, s[32:35], s36 offen nt
  s_add_u32 s36, s36, s37
  buffer_load_dwordx4 v[92:95], v50, s[32:35], s36 offen nt
  s_add_u32 s36, s36, s96
  buffer_load_dwordx4 v[96:99], v50, s[32:35], s36 offen nt
  s_add_u32 s36, s36, s37
  buffer_load_dwordx4 v[100:103], v50, s[32:35], s36 offen nt
  s_add_u32 s36, s36, s37
  buffer_load_dwordx4 v[104:107], v50, s[32:35], s36 offen nt
  s_add_u32 s36, s36, s37
  buffer_load_dwordx4 v[108:111], v50, s[32:35], s36 offen nt
  s_add_u32 s36, s36, s37
  buffer_load_dwordx4 v[112:115], v50, s[32:35], s36 offen nt
  s_add_u32 s36, s36, s37
  buffer_load_dwordx4 v[116:119], v50, s[32:35], s36 offen nt
  s_add_u32 s36, s36, s37
  buffer_load_dwordx4 v[120:123], v50, s[32:35], s36 offen nt
  s_add_u32 s36, s36, s37
  buffer_load_dwordx4 v[124:127], v50, s[32:35], s36 offen nt
  s_barrier
  s_branch L_roleQ2
L_notq:
  s_cmp_lt_u32 s3, 4
  s_cbranch_scc1 L_fo
  s_sub_u32 s3, s3, 4
  s_lshl_b32 s96, s4, 24
  s_lshr_b32 s97, s5, 3
  s_lshl_b32 s97, s97, 18
  s_add_u32 s96, s96, s97
  s_and_b32 s97, s5, 7
  s_lshl_b32 s97, s97, 10
  s_add_u32 s96, s96, s97
  s_lshl_b32 s97, s3, 13
  s_add_u32 s96, s96, s97
  s_add_u32 s96, s96, 15728640
  s_add_u32 s97, s96, 131072
  v_and_b32 v8, 3, v0
  v_lshlrev_b32 v8, 15, v8
  v_bfe_u32 v9, v0, 2, 2
  v_lshl_add_u32 v8, v9, 8, v8
  v_lshrrev_b32 v2, 4, v0
  v_lshl_add_u32 v8, v2, 4, v8
  s_mov_b32 s34, 134217728
  s_mov_b32 s35, 0x20000
  s_waitcnt lgkmcnt(0)
  s_mov_b32 s32, s10
  s_and_b32 s33, s11, 0xffff
  s_barrier
  buffer_load_dwordx4 v[64:67], v8, s[32:35], s96 offen offset:0 nt
  buffer_load_dwordx4 v[68:71], v8, s[32:35], s96 offen offset:64 nt
  buffer_load_dwordx4 v[72:75], v8, s[32:35], s96 offen offset:128 nt
  buffer_load_dwordx4 v[76:79], v8, s[32:35], s96 offen offset:192 nt
  buffer_load_dwordx4 v[80:83], v8, s[32:35], s97 offen offset:0 nt
  buffer_load_dwordx4 v[84:87], v8, s[32:35], s97 offen offset:64 nt
  buffer_load_dwordx4 v[88:91], v8, s[32:35], s97 offen offset:128 nt
  buffer_load_dwordx4 v[92:95], v8, s[32:35], s97 offen offset:192 nt
  s_branch L_roleA
L_fo:
  s_barrier
  s_cmp_lt_u32 s3, 2
  s_cbranch_scc1 L_roleF
  s_branch L_roleO2
L_core:
  s_waitcnt vmcnt(16) lgkmcnt(0)
  s_add_u32 s7, s6, 1
  s_mul_i32 s6, s7, 0x01010101
  s_xor_b32 s6, s6, 0x5c3a96f0
  s_and_b32 s56, s6, 0xffff
  s_and_b32 s57, s6, 0xffff0000
  v_mov_b32 v254, s6
  v_lshlrev_b32 v16, 16, v4
  v_and_b32 v17, 0xffff0000, v4
  v_lshlrev_b32 v18, 16, v5
  v_and_b32 v19, 0xffff0000, v5
  v_lshlrev_b32 v20, 16, v6
  v_and_b32 v21, 0xffff0000, v6
  v_lshlrev_b32 v22, 16, v7
  v_and_b32 v23, 0xffff0000, v7
  v_add_f32 v24, v16, v17
  v_add_f32 v25, v18, v19
  v_add_f32 v26, v20, v21
  v_add_f32 v27, v22, v23
  v_add_f32 v24, v24, v25
  v_add_f32 v26, v26, v27
  v_add_f32 v24, v24, v26
  s_nop 1
  v_add_f32_dpp v24, v24, v24 row_ror:8 row_mask:0xf bank_mask:0xf
  s_nop 1
  v_add_f32_dpp v24, v24, v24 row_ror:4 row_mask:0xf bank_mask:0xf
  s_nop 1
  v_add_f32_dpp v24, v24, v24 row_ror:2 row_mask:0xf bank_mask:0xf
  s_nop 1
  v_add_f32_dpp v24, v24, v24 row_ror:1 row_mask:0xf bank_mask:0xf
  s_nop 1
  v_add_f32_dpp v24, v24, v24 row_bcast:15 row_mask:0xa bank_mask:0xf
  s_nop 1
  v_add_f32_dpp v24, v24, v24 row_bcast:31 row_mask:0xc bank_mask:0xf
  s_nop 0
  v_readlane_b32 s60, v24, 63
  v_mov_b32 v25, 0x3b000000
  s_nop 0
  v_mul_f32 v25, s60, v25
  v_sub_f32 v32, v16, v25
  v_sub_f32 v33, v17, v25
  v_sub_f32 v34, v18, v25
  v_sub_f32 v35, v19, v25
  v_sub_f32 v36, v20, v25
  v_sub_f32 v37, v21, v25
  v_sub_f32 v38, v22, v25
  v_sub_f32 v39, v23, v25
  v_mul_f32 v24, v32, v32
  v_fmac_f32 v24, v33, v33
  v_fmac_f32 v24, v34, v34
  v_fmac_f32 v24, v35, v35
  v_fmac_f32 v24, v36, v36
  v_fmac_f32 v24, v37, v37
  v_fmac_f32 v24, v38, v38
  v_fmac_f32 v24, v39, v39
  s_nop 1
  v_add_f32_dpp v24, v24, v24 row_ror:8 row_mask:0xf bank_mask:0xf
  s_nop 1
  v_add_f32_dpp v24, v24, v24 row_ror:4 row_mask:0xf bank_mask:0xf
  s_nop 1
  v_add_f32_dpp v24, v24, v24 row_ror:2 row_mask:0xf bank_mask:0xf
  s_nop 1
  v_add_f32_dpp v24, v24, v24 row_ror:1 row_mask:0xf bank_mask:0xf
  s_nop 1
  v_add_f32_dpp v24, v24, v24 row_bcast:15 row_mask:0xa bank_mask:0xf
  s_nop 1
  v_add_f32_dpp v24, v24, v24 row_bcast:31 row_mask:0xc bank_mask:0xf
  s_nop 0
  v_readlane_b32 s61, v24, 63
  v_mov_b32 v26, 0x3b000000
  s_nop 0
  v_mul_f32 v26, s61, v26
  v_cvt_pk_bf16_f32 v28, v25, v26
  v_lshlrev_b32 v29, 16, v28
  v_and_b32 v30, 0xffff0000, v28
  v_add_f32 v30, 0x3727c5ac, v30
  v_cvt_pk_bf16_f32 v30, v30, v30
  v_and_b32 v30, 0xffff0000, v30
  v_sqrt_f32 v30, v30
  s_nop 0
  v_cvt_pk_bf16_f32 v30, v30, v30
  v_and_b32 v30, 0xffff0000, v30
  v_rcp_f32 v30, v30
  v_sub_f32 v32, v16, v29
  v_sub_f32 v33, v17, v29
  v_sub_f32 v34, v18, v29
  v_sub_f32 v35, v19, v29
  v_sub_f32 v36, v20, v29
  v_sub_f32 v37, v21, v29
  v_sub_f32 v38, v22, v29
  v_sub_f32 v39, v23, v29
  v_cvt_pk_bf16_f32 v40, v32, v33
  v_cvt_pk_bf16_f32 v41, v34, v35
  v_cvt_pk_bf16_f32 v42, v36, v37
  v_cvt_pk_bf16_f32 v43, v38, v39
  v_lshlrev_b32 v32, 16, v40
  v_and_b32 v33, 0xffff0000, v40
  v_lshlrev_b32 v34, 16, v41
  v_and_b32 v35, 0xffff0000, v41
  v_lshlrev_b32 v36, 16, v42
  v_and_b32 v37, 0xffff0000, v42
  v_lshlrev_b32 v38, 16, v43
  v_and_b32 v39, 0xffff0000, v43
  v_mul_f32 v32, v32, v30
  v_mul_f32 v33, v33, v30
  v_mul_f32 v34, v34, v30
  v_mul_f32 v35, v35, v30
  v_mul_f32 v36, v36, v30
  v_mul_f32 v37, v37, v30
  v_mul_f32 v38, v38, v30
  v_mul_f32 v39, v39, v30
  v_cvt_pk_bf16_f32 v40, v32, v33
  v_cvt_pk_bf16_f32 v41, v34, v35
  v_cvt_pk_bf16_f32 v42, v36, v37
  v_cvt_pk_bf16_f32 v43, v38, v39
  v_add_u32 v8, s95, v8
  v_and_b32 v17, 1, v3
  v_lshlrev_b32 v17, 4, v17
  v_lshl_add_u32 v17, v2, 5, v17
  s_add_u32 s60, s38, s95
  ds_write_b128 v8, v[40:43]
  v_add_u32 v17, s60, v17
  ds_read_b128 v[8:11], v17
  ds_read_b128 v[12:15], v17 offset:128
  s_cmp_eq_u32 s101, 1
  s_cbranch_scc0 L_core_g
  s_barrier
  s_barrier
L_core_g:
  s_waitcnt vmcnt(8) lgkmcnt(0)
  v_perm_b32 v160, v68, v64, s48
  v_perm_b32 v161, v76, v72, s48
  v_perm_b32 v162, v84, v80, s48
  v_perm_b32 v163, v92, v88, s48
  v_perm_b32 v164, v68, v64, s49
  v_perm_b32 v165, v76, v72, s49
  v_perm_b32 v166, v84, v80, s49
  v_perm_b32 v167, v92, v88, s49
  v_mfma_f32_16x16x32_bf16 v[128:131], v[8:11], v[160:163], 0
  v_perm_b32 v160, v69, v65, s48
  v_perm_b32 v161, v77, v73, s48
  v_perm_b32 v162, v85, v81, s48
  v_perm_b32 v163, v93, v89, s48
  v_mfma_f32_16x16x32_bf16 v[132:135], v[8:11], v[164:167], 0
  v_perm_b32 v164, v69, v65, s49
  v_perm_b32 v165, v77, v73, s49
  v_perm_b32 v166, v85, v81, s49
  v_perm_b32 v167, v93, v89, s49
  v_mfma_f32_16x16x32_bf16 v[136:139], v[8:11], v[160:163], 0
  v_perm_b32 v160, v70, v66, s48
  v_perm_b32 v161, v78, v74, s48
  v_perm_b32 v162, v86, v82, s48
  v_perm_b32 v163, v94, v90, s48
  v_mfma_f32_16x16x32_bf16 v[140:143], v[8:11], v[164:167], 0
  v_perm_b32 v164, v70, v66, s49
  v_perm_b32 v165, v78, v74, s49
  v_perm_b32 v166, v86, v82, s49
  v_perm_b32 v167, v94, v90, s49
  v_mfma_f32_16x16x32_bf16 v[144:147], v[8:11], v[160:163], 0
  v_perm_b32 v160, v71, v67, s48
  v_perm_b32 v161, v79, v75, s48
  v_perm_b32 v162, v87, v83, s48
  v_perm_b32 v163, v95, v91, s48
  v_mfma_f32_16x16x32_bf16 v[148:151], v[8:11], v[164:167], 0
  v_perm_b32 v164, v71, v67, s49
  v_perm_b32 v165, v79, v75, s49
  v_perm_b32 v166, v87, v83, s49
  v_perm_b32 v167, v95, v91, s49
  v_mfma_f32_16x16x32_bf16 v[152:155], v[8:11], v[160:163], 0
  s_nop 0
  v_mfma_f32_16x16x32_bf16 v[156:159], v[8:11], v[164:167], 0
  s_waitcnt vmcnt(0)
  v_perm_b32 v160, v100, v96, s48
  v_perm_b32 v161, v108, v104, s48
  v_perm_b32 v162, v116, v112, s48
  v_perm_b32 v163, v124, v120, s48
  v_perm_b32 v164, v100, v96, s49
  v_perm_b32 v165, v108, v104, s49
  v_perm_b32 v166, v116, v112, s49
  v_perm_b32 v167, v124, v120, s49
  v_mfma_f32_16x16x32_bf16 v[128:131], v[12:15], v[160:163], v[128:131]
  v_perm_b32 v160, v101, v97, s48
  v_perm_b32 v161, v109, v105, s48
  v_perm_b32 v162, v117, v113, s48
  v_perm_b32 v163, v125, v121, s48
  v_mfma_f32_16x16x32_bf16 v[132:135], v[12:15], v[164:167], v[132:135]
  v_perm_b32 v164, v101, v97, s49
  v_perm_b32 v165, v109, v105, s49
  v_perm_b32 v166, v117, v113, s49
  v_perm_b32 v167, v125, v121, s49
  v_mfma_f32_16x16x32_bf16 v[136:139], v[12:15], v[160:163], v[136:139]
  v_perm_b32 v160, v102, v98, s48
  v_perm_b32 v161, v110, v106, s48
  v_perm_b32 v162, v118, v114, s48
  v_perm_b32 v163, v126, v122, s48
  v_mfma_f32_16x16x32_bf16 v[140:143], v[12:15], v[164:167], v[140:143]
  v_perm_b32 v164, v102, v98, s49
  v_perm_b32 v165, v110, v106, s49
  v_perm_b32 v166, v118, v114, s49
  v_perm_b32 v167, v126, v122, s49
  v_mfma_f32_16x16x32_bf16 v[144:147], v[12:15], v[160:163], v[144:147]
  v_perm_b32 v160, v103, v99, s48
  v_perm_b32 v161, v111, v107, s48
  v_perm_b32 v162, v119, v115, s48
  v_perm_b32 v163, v127, v123, s48
  v_mfma_f32_16x16x32_bf16 v[148:151], v[12:15], v[164:167], v[148:151]
  v_perm_b32 v164, v103, v99, s49
  v_perm_b32 v165, v111, v107, s49
  v_perm_b32 v166, v119, v115, s49
  v_perm_b32 v167, v127, v123, s49
  v_mfma_f32_16x16x32_bf16 v[152:155], v[12:15], v[160:163], v[152:155]
  s_nop 0
  v_mfma_f32_16x16x32_bf16 v[156:159], v[12:15], v[164:167], v[156:159]
  v_and_b32 v16, 8, v0
  v_cmp_ne_u32 s[62:63], 0, v16
  s_nop 1
  v_cndmask_b32 v20, v128, v145, s[62:63]
  v_cndmask_b32 v24, v144, v129, s[62:63]
  v_cndmask_b32 v21, v132, v149, s[62:63]
  v_cndmask_b32 v25, v148, v133, s[62:63]
  v_cndmask_b32 v22, v136, v153, s[62:63]
  v_cndmask_b32 v26, v152, v137, s[62:63]
  v_cndmask_b32 v23, v140, v157, s[62:63]
  v_cndmask_b32 v27, v156, v141, s[62:63]
  v_add_f32_dpp v200, v24, v20 row_ror:8 row_mask:0xf bank_mask:0xf
  v_add_f32_dpp v201, v25, v21 row_ror:8 row_mask:0xf bank_mask:0xf
  v_add_f32_dpp v202, v26, v22 row_ror:8 row_mask:0xf bank_mask:0xf
  v_add_f32_dpp v203, v27, v23 row_ror:8 row_mask:0xf bank_mask:0xf
  s_cmp_eq_u32 s101, 0
  s_cbranch_scc1 L_roleQ3
  s_cmp_eq_u32 s101, 1
  s_cbranch_scc1 L_roleF3
  s_branch L_roleO2
L_roleQ2:
  s_setprio 3
  s_and_b32 s96, s5, 7
  s_lshl_b32 s38, s97, 8
  s_lshl_b32 s39, s4, 13
  s_lshl_b32 s98, s97, 11
  s_add_u32 s39, s39, s98
  s_lshl_b32 s98, s96, 8
  s_add_u32 s39, s39, s98
  s_add_u32 s39, s39, 65536
  v_lshrrev_b32 v2, 4, v0
  v_and_b32 v3, 15, v0
  s_mov_b32 s48, 0x05040100
  s_mov_b32 s49, 0x07060302
  s_mov_b32 s50, 0x07060500
  s_mov_b32 s51, 0x07060501
  s_mov_b32 s52, 0x07060502
  s_mov_b32 s53, 0x07060503
  s_mov_b32 s54, 0x0c0c0400
  s_mov_b32 s55, 0x04000c0c
  s_mov_b32 s58, 0xffffff00
  s_load_dword s6, s[30:31], 0
  s_mov_b32 s40, s30
  s_and_b32 s41, s31, 0xffff
  s_mov_b32 s42, 536870912
  s_mov_b32 s43, 0x20000
  v_and_b32 v16, 8, v0
  v_and_b32 v204, 7, v0
  v_lshlrev_b32 v204, 5, v204
  v_lshl_add_u32 v204, v16, 1, v204
  s_lshl_b32 s60, s4, 9
  s_lshl_b32 s61, s5, 4
  s_add_u32 s60, s60, s61
  s_add_u32 s60, s60, 229376
  s_sub_u32 s60, s60, s39
  v_cmp_eq_u32 vcc, 16, v0
  v_mov_b32 v18, s60
  s_nop 0
  v_cndmask_b32 v204, v204, v18, vcc
  v_mov_b32 v16, 0
  v_lshlrev_b32 v17, 2, v0
  s_mov_b32 exec_lo, -1
  s_mov_b32 exec_hi, 0
  ds_write_b32 v17, v16 offset:12416
  s_mov_b64 exec, -1
  s_mov_b32 s101, 0
  s_mov_b32 s95, 0
  s_branch L_core
L_roleQ3:
  s_getreg_b32 s60, hwreg(HW_REG_XCC_ID)
  s_and_b32 s60, s60, 0xffff
  s_lshl_b32 s37, s60, 8
  v_cmp_eq_u32 vcc, 16, v0
  v_mov_b32 v16, s37
  s_nop 0
  v_cndmask_b32 v200, v200, v16, vcc
  v_cndmask_b32 v201, v201, v16, vcc
  v_cndmask_b32 v202, v202, v16, vcc
  v_cndmask_b32 v203, v203, v16, vcc
  v_perm_b32 v200, v200, v254, s50
  v_perm_b32 v201, v201, v254, s51
  v_perm_b32 v202, v202, v254, s52
  v_perm_b32 v203, v203, v254, s53
  s_mov_b32 exec_lo, 0x1ffff
  s_mov_b32 exec_hi, 0
  buffer_load_dwordx4 v[208:211], v204, s[40:43], s39 offen sc1
  buffer_store_dwordx4 v[200:203], v204, s[40:43], s39 offen
  s_mov_b64 exec, -1
  s_add_u32 s38, s39, 786432
  s_barrier
  s_lshl_b32 s98, s4, 9
  s_add_u32 s98, s98, 229376
  v_and_b32 v9, 31, v0
  v_lshlrev_b32 v9, 4, v9
  s_mov_b32 s97, 786432
  s_mov_b32 s59, 0
  s_barrier
  buffer_load_dwordx4 v[96:99], v9, s[40:43], s98 offen sc1
  s_barrier
  s_branch L_qchk
L_qretry:
  buffer_load_dwordx4 v[96:99], v9, s[40:43], s98 offen sc1
L_qchk:
  s_waitcnt vmcnt(0)
  v_perm_b32 v18, v97, v96, s54
  v_perm_b32 v19, v99, v98, s55
  v_xor_b32 v16, s56, v18
  v_bitop3_b32 v16, v16, v19, s57 bitop3:0xf6
  v_cmp_ne_u32 vcc, 0, v16
  s_add_u32 s59, s59, 1
  s_cbranch_vccz L_qok
  s_cmp_eq_u32 s59, 24
  s_cbranch_scc0 L_qretry_ns
  s_mov_b32 exec_lo, 0x1ffff
  s_mov_b32 exec_hi, 0
  buffer_store_dwordx4 v[200:203], v204, s[40:43], s38 offen sc1
  s_mov_b64 exec, -1
L_qretry_ns:
  s_sub_u32 s61, 0, s97
  s_cmp_ge_u32 s59, 48
  s_cselect_b32 s95, s97, 0
  s_cselect_b32 s97, s61, s97
  s_add_u32 s98, s98, s95
  s_cmp_gt_u32 s59, 16384
  s_cbranch_scc1 L_qok
  s_sleep 1
  s_branch L_qretry
L_qok:
  v_and_b32 v96, s58, v96
  v_cmp_ne_u32 vcc, s37, v96
  v_mov_b32 v19, 0
  s_nop 2
  s_cmp_lg_u64 vcc, 0
  s_cselect_b32 s60, 3, 1
  s_cmp_ge_u32 s59, 24
  s_cselect_b32 s60, 3, s60
  v_mov_b32 v18, s60
  s_nop 0
  ds_write_b32 v19, v18 offset:12416
  s_cmp_eq_u32 s60, 1
  s_cbranch_scc1 L_qend
  s_mov_b32 exec_lo, 0x1ffff
  s_mov_b32 exec_hi, 0
  buffer_store_dwordx4 v[200:203], v204, s[40:43], s38 offen sc1
  s_mov_b64 exec, -1
L_qend:
  s_branch L_end
L_roleF:
  v_lshrrev_b32 v2, 4, v0
  v_and_b32 v3, 15, v0
  s_mov_b32 s48, 0x05040100
  s_mov_b32 s49, 0x07060302
  s_mov_b32 s50, 0x07060500
  s_mov_b32 s51, 0x07060501
  s_mov_b32 s52, 0x07060502
  s_mov_b32 s53, 0x07060503
  s_mov_b32 s54, 0x0c0c0400
  s_mov_b32 s55, 0x04000c0c
  s_mov_b32 s58, 0xffffff00
  s_lshl_b32 s96, s4, 2
  s_mul_i32 s97, s4, 3
  s_add_u32 s97, s97, 4
  s_cmp_lt_u32 s4, 4
  s_cselect_b32 s96, s96, s97
  s_cselect_b32 s97, 32, 24
  s_cmp_lt_u32 s5, s97
  s_cselect_b32 s100, 1, 0
  s_lshr_b32 s97, s5, 3
  s_add_u32 s98, s96, s97
  s_lshr_b32 s99, s5, 1
  s_and_b32 s99, s99, 3
  s_mul_i32 s36, s99, 458752
  s_lshl_b32 s98, s98, 7
  s_add_u32 s36, s36, s98
  s_mov_b32 s37, 3584
  s_lshl_b32 s38, s99, 8
  s_lshl_b32 s39, s4, 13
  s_and_b32 s101, s5, 1
  s_lshl_b32 s98, s101, 12
  s_add_u32 s39, s39, s98
  s_lshl_b32 s98, s99, 10
  s_add_u32 s39, s39, s98
  s_lshl_b32 s98, s97, 8
  s_add_u32 s39, s39, s98
  s_add_u32 s39, s39, 131072
  s_lshl_b32 s96, s96, 16
  s_lshr_b32 s97, s5, 2
  s_lshl_b32 s98, s97, 15
  s_add_u32 s98, s98, s96
  s_and_b32 s97, s5, 3
  s_lshl_b32 s99, s97, 8
  s_add_u32 s98, s98, s99
  s_add_u32 s99, s98, 4096
  s_mov_b32 s96, 204288
  v_and_b32 v50, 56, v0
  v_mul_u32_u24 v50, 3584, v50
  v_and_b32 v10, 7, v0
  v_lshl_add_u32 v50, v10, 4, v50
  v_lshlrev_b32 v8, 4, v0
  s_setprio 2
  s_waitcnt lgkmcnt(0)
  s_mov_b32 s44, s8
  s_and_b32 s45, s9, 0xffff
  s_mov_b32 s46, 1024
  s_mov_b32 s47, 0x20000
  buffer_load_dwordx4 v[4:7], v8, s[44:47], 0 offen
  s_cmp_eq_u32 s101, 0
  s_cselect_b32 s60, s20, s22
  s_cselect_b32 s61, s21, s23
  s_mov_b32 s32, s60
  s_and_b32 s33, s61, 0xffff
  s_mov_b32 s34, 1835008
  s_mov_b32 s35, 0x20000
  s_cmp_eq_u32 s100, 0
  s_cbranch_scc1 L_fskip
  s_mov_b32 s40, s30
  s_and_b32 s41, s31, 0xffff
  s_mov_b32 s42, 536870912
  s_mov_b32 s43, 0x20000
  v_and_b32 v16, 8, v0
  v_and_b32 v204, 7, v0
  v_lshlrev_b32 v204, 5, v204
  v_lshl_add_u32 v204, v16, 1, v204
  buffer_load_dwordx4 v[64:67], v50, s[32:35], s36 offen nt
  s_add_u32 s36, s36, s37
  buffer_load_dwordx4 v[68:71], v50, s[32:35], s36 offen nt
  s_add_u32 s36, s36, s37
  buffer_load_dwordx4 v[72:75], v50, s[32:35], s36 offen nt
  s_add_u32 s36, s36, s37
  buffer_load_dwordx4 v[76:79], v50, s[32:35], s36 offen nt
  s_add_u32 s36, s36, s37
  buffer_load_dwordx4 v[80:83], v50, s[32:35], s36 offen nt
  s_add_u32 s36, s36, s37
  buffer_load_dwordx4 v[84:87], v50, s[32:35], s36 offen nt
  s_add_u32 s36, s36, s37
  buffer_load_dwordx4 v[88:91], v50, s[32:35], s36 offen nt
  s_add_u32 s36, s36, s37
  buffer_load_dwordx4 v[92:95], v50, s[32:35], s36 offen nt
  s_add_u32 s36, s36, s96
  buffer_load_dwordx4 v[96:99], v50, s[32:35], s36 offen nt
  s_add_u32 s36, s36, s37
  buffer_load_dwordx4 v[100:103], v50, s[32:35], s36 offen nt
  s_add_u32 s36, s36, s37
  buffer_load_dwordx4 v[104:107], v50, s[32:35], s36 offen nt
  s_add_u32 s36, s36, s37
  buffer_load_dwordx4 v[108:111], v50, s[32:35], s36 offen nt
  s_add_u32 s36, s36, s37
  buffer_load_dwordx4 v[112:115], v50, s[32:35], s36 offen nt
  s_add_u32 s36, s36, s37
  buffer_load_dwordx4 v[116:119], v50, s[32:35], s36 offen nt
  s_add_u32 s36, s36, s37
  buffer_load_dwordx4 v[120:123], v50, s[32:35], s36 offen nt
  s_add_u32 s36, s36, s37
  buffer_load_dwordx4 v[124:127], v50, s[32:35], s36 offen nt
  s_load_dword s6, s[30:31], 0
  s_barrier
  s_mov_b32 exec_lo, 0xffff
  s_mov_b32 exec_hi, 0
  buffer_load_dwordx4 v[208:211], v204, s[40:43], s39 offen sc1
  s_mov_b64 exec, -1
  s_mov_b32 s101, 1
  s_movk_i32 s95, 1024
  s_branch L_core
L_roleF3:
  s_mov_b32 s44, s24
  s_and_b32 s45, s25, 0xffff
  s_mov_b32 s46, 1835008
  s_mov_b32 s47, 0x20000
  v_lshlrev_b32 v51, 13, v2
  v_lshl_add_u32 v51, v3, 4, v51
  s_setprio 0
  v_perm_b32 v200, v200, v254, s50
  v_perm_b32 v201, v201, v254, s51
  v_perm_b32 v202, v202, v254, s52
  v_perm_b32 v203, v203, v254, s53
  s_mov_b32 exec_lo, 0xffff
  s_mov_b32 exec_hi, 0
  buffer_store_dwordx4 v[200:203], v204, s[40:43], s39 offen
  s_mov_b64 exec, -1
  s_add_u32 s38, s39, 786432
  buffer_load_dwordx4 v[168:171], v51, s[44:47], s98 offen offset:0 nt
  buffer_load_dwordx4 v[172:175], v51, s[44:47], s98 offen offset:1024 nt
  buffer_load_dwordx4 v[176:179], v51, s[44:47], s98 offen offset:2048 nt
  buffer_load_dwordx4 v[180:183], v51, s[44:47], s98 offen offset:3072 nt
  buffer_load_dwordx4 v[184:187], v51, s[44:47], s99 offen offset:0 nt
  buffer_load_dwordx4 v[188:191], v51, s[44:47], s99 offen offset:1024 nt
  buffer_load_dwordx4 v[192:195], v51, s[44:47], s99 offen offset:2048 nt
  buffer_load_dwordx4 v[196:199], v51, s[44:47], s99 offen offset:3072 nt
  v_lshrrev_b32 v56, 3, v3
  v_lshlrev_b32 v56, 12, v56
  v_and_b32 v57, 3, v3
  v_lshl_add_u32 v56, v57, 10, v56
  v_and_b32 v57, 4, v3
  v_lshl_add_u32 v56, v57, 2, v56
  v_lshl_add_u32 v56, v2, 5, v56
  s_lshl_b32 s98, s4, 13
  s_lshr_b32 s99, s5, 2
  s_lshl_b32 s96, s99, 7
  s_add_u32 s98, s98, s96
  s_add_u32 s98, s98, 131072
  s_mov_b32 s96, 786432
  s_mov_b32 s59, 0
  v_and_b32 v12, 16, v0
  v_cmp_ne_u32 s[62:63], 0, v12
  v_lshlrev_b32 v13, 5, v3
  v_lshl_add_u32 v13, v2, 4, v13
  s_waitcnt vmcnt(6)
  v_perm_b32 v64, v172, v168, s48
  v_perm_b32 v68, v172, v168, s49
  v_perm_b32 v72, v173, v169, s48
  v_perm_b32 v76, v173, v169, s49
  v_perm_b32 v80, v174, v170, s48
  v_perm_b32 v84, v174, v170, s49
  v_perm_b32 v88, v175, v171, s48
  v_perm_b32 v92, v175, v171, s49
  buffer_load_dwordx4 v[32:35], v56, s[40:43], s98 offen sc1
  s_waitcnt vmcnt(5)
  v_perm_b32 v65, v180, v176, s48
  v_perm_b32 v69, v180, v176, s49
  v_perm_b32 v73, v181, v177, s48
  v_perm_b32 v77, v181, v177, s49
  v_perm_b32 v81, v182, v178, s48
  v_perm_b32 v85, v182, v178, s49
  v_perm_b32 v89, v183, v179, s48
  v_perm_b32 v93, v183, v179, s49
  s_waitcnt vmcnt(3)
  v_perm_b32 v66, v188, v184, s48
  v_perm_b32 v70, v188, v184, s49
  v_perm_b32 v74, v189, v185, s48
  v_perm_b32 v78, v189, v185, s49
  v_perm_b32 v82, v190, v186, s48
  v_perm_b32 v86, v190, v186, s49
  v_perm_b32 v90, v191, v187, s48
  v_perm_b32 v94, v191, v187, s49
  s_waitcnt vmcnt(1)
  v_perm_b32 v67, v196, v192, s48
  v_perm_b32 v71, v196, v192, s49
  v_perm_b32 v75, v197, v193, s48
  v_perm_b32 v79, v197, v193, s49
  v_perm_b32 v83, v198, v194, s48
  v_perm_b32 v87, v198, v194, s49
  v_perm_b32 v91, v199, v195, s48
  v_perm_b32 v95, v199, v195, s49
L_gpoll:
  buffer_load_dwordx4 v[36:39], v56, s[40:43], s98 offen sc1
  s_waitcnt vmcnt(1)
  v_perm_b32 v14, v33, v32, s54
  v_perm_b32 v15, v35, v34, s55
  v_xor_b32 v12, s56, v14
  v_bitop3_b32 v12, v12, v15, s57 bitop3:0xf6
  v_cmp_ne_u32 vcc, 0, v12
  s_cbranch_vccz L_gokA
  buffer_load_dwordx4 v[32:35], v56, s[40:43], s98 offen sc1
  s_waitcnt vmcnt(1)
  v_perm_b32 v14, v37, v36, s54
  v_perm_b32 v15, v39, v38, s55
  v_xor_b32 v12, s56, v14
  v_bitop3_b32 v12, v12, v15, s57 bitop3:0xf6
  v_cmp_ne_u32 vcc, 0, v12
  s_add_u32 s59, s59, 1
  s_cbranch_vccz L_gokB
  s_cmp_eq_u32 s59, 24
  s_cbranch_scc0 L_gpoll_ns
  s_mov_b32 exec_lo, 0xffff
  s_mov_b32 exec_hi, 0
  buffer_store_dwordx4 v[200:203], v204, s[40:43], s38 offen sc1
  s_mov_b64 exec, -1
L_gpoll_ns:
  s_sub_u32 s61, 0, s96
  s_cmp_ge_u32 s59, 48
  s_cselect_b32 s95, s96, 0
  s_cselect_b32 s96, s61, s96
  s_add_u32 s98, s98, s95
  s_cmp_gt_u32 s59, 16384
  s_cbranch_scc1 L_gokB
  s_sleep 1
  s_branch L_gpoll
L_gokB:
  v_and_b32 v40, s58, v36
  v_and_b32 v41, s58, v37
  v_and_b32 v42, s58, v38
  v_and_b32 v43, s58, v39
  s_branch L_gok
L_gokA:
  v_and_b32 v40, s58, v32
  v_and_b32 v41, s58, v33
  v_and_b32 v42, s58, v34
  v_and_b32 v43, s58, v35
L_gok:
  v_add_f32_dpp v40, v40, v40 quad_perm:[1,0,3,2] row_mask:0xf bank_mask:0xf
  v_add_f32_dpp v41, v41, v41 quad_perm:[1,0,3,2] row_mask:0xf bank_mask:0xf
  v_add_f32_dpp v42, v42, v42 quad_perm:[1,0,3,2] row_mask:0xf bank_mask:0xf
  v_add_f32_dpp v43, v43, v43 quad_perm:[1,0,3,2] row_mask:0xf bank_mask:0xf
  v_add_f32_dpp v40, v40, v40 quad_perm:[2,3,0,1] row_mask:0xf bank_mask:0xf
  v_add_f32_dpp v41, v41, v41 quad_perm:[2,3,0,1] row_mask:0xf bank_mask:0xf
  v_add_f32_dpp v42, v42, v42 quad_perm:[2,3,0,1] row_mask:0xf bank_mask:0xf
  v_add_f32_dpp v43, v43, v43 quad_perm:[2,3,0,1] row_mask:0xf bank_mask:0xf
  v_cvt_pk_bf16_f32 v44, v40, v41
  v_cvt_pk_bf16_f32 v45, v42, v43
  v_lshlrev_b32 v40, 16, v44
  v_and_b32 v41, 0xffff0000, v44
  v_lshlrev_b32 v42, 16, v45
  v_and_b32 v43, 0xffff0000, v45
  v_and_b32 v12, 8, v0
  v_cmp_ne_u32 vcc, 0, v12
  v_mov_b32_dpp v44, v40 row_ror:8 row_mask:0xf bank_mask:0xf
  v_mov_b32_dpp v45, v41 row_ror:8 row_mask:0xf bank_mask:0xf
  v_mov_b32_dpp v46, v42 row_ror:8 row_mask:0xf bank_mask:0xf
  v_mov_b32_dpp v47, v43 row_ror:8 row_mask:0xf bank_mask:0xf
  v_cndmask_b32 v48, v40, v44, vcc
  v_cndmask_b32 v52, v44, v40, vcc
  v_cndmask_b32 v49, v41, v45, vcc
  v_cndmask_b32 v53, v45, v41, vcc
  v_cndmask_b32 v50, v42, v46, vcc
  v_cndmask_b32 v54, v46, v42, vcc
  v_cndmask_b32 v51, v43, v47, vcc
  v_cndmask_b32 v55, v47, v43, vcc
  s_mov_b32 s60, 0x3d372713
  s_mov_b32 s61, 0xc0135761
  v_mul_f32 v40, v48, v48
  v_mul_f32 v41, v49, v49
  v_mul_f32 v42, v50, v50
  v_mul_f32 v43, v51, v51
  v_fma_f32 v40, v40, s60, 1.0
  v_fma_f32 v41, v41, s60, 1.0
  v_fma_f32 v42, v42, s60, 1.0
  v_fma_f32 v43, v43, s60, 1.0
  v_mul_f32 v40, v40, v48
  v_mul_f32 v41, v41, v49
  v_mul_f32 v42, v42, v50
  v_mul_f32 v43, v43, v51
  v_mul_f32 v40, s61, v40
  v_mul_f32 v41, s61, v41
  v_mul_f32 v42, s61, v42
  v_mul_f32 v43, s61, v43
  v_exp_f32 v40, v40
  v_exp_f32 v41, v41
  v_exp_f32 v42, v42
  v_exp_f32 v43, v43
  v_add_f32 v40, 1.0, v40
  v_add_f32 v41, 1.0, v41
  v_add_f32 v42, 1.0, v42
  v_add_f32 v43, 1.0, v43
  v_rcp_f32 v40, v40
  v_rcp_f32 v41, v41
  v_rcp_f32 v42, v42
  v_rcp_f32 v43, v43
  v_mul_f32 v40, v40, v48
  v_mul_f32 v41, v41, v49
  v_mul_f32 v42, v42, v50
  v_mul_f32 v43, v43, v51
  v_cvt_pk_bf16_f32 v44, v40, v41
  v_cvt_pk_bf16_f32 v45, v42, v43
  v_lshlrev_b32 v40, 16, v44
  v_and_b32 v41, 0xffff0000, v44
  v_lshlrev_b32 v42, 16, v45
  v_and_b32 v43, 0xffff0000, v45
  v_mul_f32 v40, v40, v52
  v_mul_f32 v41, v41, v53
  v_mul_f32 v42, v42, v54
  v_mul_f32 v43, v43, v55
  v_cvt_pk_bf16_f32 v44, v40, v41
  v_cvt_pk_bf16_f32 v45, v42, v43
  v_and_b32 v12, 4, v0
  v_cmp_ne_u32 vcc, 0, v12
  v_mov_b32_dpp v46, v44 row_ror:4 row_mask:0xf bank_mask:0xf
  v_mov_b32_dpp v47, v45 row_ror:4 row_mask:0xf bank_mask:0xf
  v_cndmask_b32 v24, v44, v46, vcc
  v_cndmask_b32 v25, v45, v47, vcc
  v_cndmask_b32 v26, v46, v44, vcc
  v_cndmask_b32 v27, v47, v45, vcc
  s_nop 1
  v_mfma_f32_16x16x32_bf16 v[128:131], v[24:27], v[64:67], 0
  v_mfma_f32_16x16x32_bf16 v[132:135], v[24:27], v[68:71], 0
  v_mfma_f32_16x16x32_bf16 v[136:139], v[24:27], v[72:75], 0
  v_mfma_f32_16x16x32_bf16 v[140:143], v[24:27], v[76:79], 0
  v_mfma_f32_16x16x32_bf16 v[144:147], v[24:27], v[80:83], 0
  v_mfma_f32_16x16x32_bf16 v[148:151], v[24:27], v[84:87], 0
  v_mfma_f32_16x16x32_bf16 v[152:155], v[24:27], v[88:91], 0
  v_mfma_f32_16x16x32_bf16 v[156:159], v[24:27], v[92:95], 0
  s_nop 4
  v_cndmask_b32 v16, v128, v144, s[62:63]
  v_cndmask_b32 v17, v132, v148, s[62:63]
  v_cndmask_b32 v18, v136, v152, s[62:63]
  v_cndmask_b32 v19, v140, v156, s[62:63]
  v_lshlrev_b32 v20, 4, v0
  v_mov_b32 v21, 0
  v_mov_b32 v22, 1
  s_mov_b32 exec_lo, -1
  s_mov_b32 exec_hi, 0
  ds_write_b128 v20, v[16:19] offset:13056
  s_mov_b64 exec, 1
  ds_add_u32 v21, v22 offset:12472
  s_mov_b64 exec, -1
  v_mov_b32 v10, 0
  s_mov_b32 s59, 0
L_fawait_col:
  ds_read_b32 v12, v10 offset:12416
  s_add_u32 s59, s59, 1
  s_waitcnt lgkmcnt(0)
  v_readfirstlane_b32 s60, v12
  s_cmp_gt_u32 s59, 262144
  s_cbranch_scc1 L_fawait_col_x
  s_cmp_lt_u32 s60, 1
  s_cbranch_scc1 L_fawait_col
L_fawait_col_x:
  s_cmp_eq_u32 s60, 1
  s_cbranch_scc1 L_end
  s_mov_b32 exec_lo, 0xffff
  s_mov_b32 exec_hi, 0
  buffer_store_dwordx4 v[200:203], v204, s[40:43], s38 offen sc1
  s_mov_b64 exec, -1
  s_branch L_end
L_fskip:
  s_barrier
  s_barrier
  s_barrier
  s_branch L_end
L_roleA:
  s_setprio 2
  v_lshrrev_b32 v2, 4, v0
  v_and_b32 v3, 15, v0
  s_mov_b32 s48, 0x05040100
  s_mov_b32 s49, 0x07060302
  s_mov_b32 s50, 0x07060500
  s_mov_b32 s51, 0x07060501
  s_mov_b32 s52, 0x07060502
  s_mov_b32 s53, 0x07060503
  s_mov_b32 s54, 0x0c0c0400
  s_mov_b32 s55, 0x04000c0c
  s_mov_b32 s58, 0xffffff00
  v_lshlrev_b32 v9, 8, v2
  v_lshl_add_u32 v9, v3, 4, v9
  s_mov_b32 s36, s12
  s_and_b32 s37, s13, 0xffff
  s_mov_b32 s38, 134217728
  s_mov_b32 s39, 0x20000
  s_load_dword s6, s[30:31], 0
  s_mov_b32 s40, s30
  s_and_b32 s41, s31, 0xffff
  s_mov_b32 s42, 536870912
  s_mov_b32 s43, 0x20000
  s_barrier
  s_mov_b32 s99, s96
  buffer_load_dwordx4 v[96:99], v9, s[36:39], s99 offen nt
  s_add_u32 s99, s99, 32768
  buffer_load_dwordx4 v[100:103], v9, s[36:39], s99 offen nt
  s_add_u32 s99, s99, 32768
  buffer_load_dwordx4 v[104:107], v9, s[36:39], s99 offen nt
  s_add_u32 s99, s99, 32768
  buffer_load_dwordx4 v[108:111], v9, s[36:39], s99 offen nt
  s_add_u32 s99, s99, 32768
  s_mov_b64 s[44:45], s[36:37]
  s_mov_b64 s[46:47], s[38:39]
  s_waitcnt lgkmcnt(0)
  s_add_u32 s7, s6, 1
  s_mul_i32 s6, s7, 0x01010101
  s_xor_b32 s6, s6, 0x5c3a96f0
  s_and_b32 s56, s6, 0xffff
  s_and_b32 s57, s6, 0xffff0000
  v_mov_b32 v254, s6
  s_lshl_b32 s36, s4, 16
  s_lshl_b32 s37, s5, 4
  s_add_u32 s36, s36, s37
  s_lshl_b32 s37, s3, 14
  s_add_u32 s36, s36, s37
  s_add_u32 s36, s36, 262144
  v_lshlrev_b32 v52, 9, v0
  v_add_u32 v52, s36, v52
  s_lshl_b32 s36, s4, 2
  s_add_u32 s36, s36, s3
  s_lshl_b32 s36, s36, 9
  s_lshl_b32 s37, s5, 4
  s_add_u32 s36, s36, s37
  s_add_u32 s36, s36, 196608
  v_mov_b32 v53, s36
  v_cmp_eq_u32 s[62:63], 32, v0
  s_lshl_b32 s36, s3, 11
  v_lshlrev_b32 v54, 9, v2
  v_lshl_add_u32 v54, v3, 5, v54
  v_add_u32 v54, s36, v54
  s_lshl_b32 s36, s3, 3
  v_lshrrev_b32 v55, 2, v3
  v_lshlrev_b32 v55, 5, v55
  v_add_u32 v55, s36, v55
  v_cndmask_b32 v52, v52, v53, s[62:63]
  s_lshl_b32 s36, s3, 9
  v_and_b32 v56, 31, v0
  v_lshlrev_b32 v56, 4, v56
  v_add_u32 v56, s36, v56
  s_lshl_b32 s36, s3, 5
  v_mov_b32 v57, s36
  s_lshl_b32 s36, s3, 2
  v_mov_b32 v58, s36
  v_mov_b32 v59, 1
  v_lshrrev_b32 v60, 2, v3
  v_lshlrev_b32 v60, 8, v60
  v_lshl_add_u32 v60, v2, 4, v60
  s_lshl_b32 s96, s4, 13
  s_lshl_b32 s97, s3, 9
  s_add_u32 s96, s96, s97
  s_add_u32 s96, s96, 65536
  v_lshrrev_b32 v61, 5, v0
  v_lshlrev_b32 v61, 11, v61
  v_and_b32 v62, 31, v0
  v_lshl_add_u32 v61, v62, 4, v61
  s_lshl_b32 s97, s3, 8
  v_lshlrev_b32 v62, 3, v62
  v_add_u32 v62, s97, v62
  s_add_u32 s97, s96, 4096
  s_mov_b32 s59, 0
  s_mov_b32 s101, 786432
  s_waitcnt vmcnt(1)
  s_barrier
  buffer_load_dwordx4 v[16:19], v61, s[40:43], s96 offen sc1
  buffer_load_dwordx4 v[20:23], v61, s[40:43], s97 offen sc1
  s_barrier
  buffer_load_dwordx4 v[112:115], v9, s[44:47], s99 offen nt
  s_add_u32 s99, s99, 32768
  buffer_load_dwordx4 v[116:119], v9, s[44:47], s99 offen nt
  s_add_u32 s99, s99, 32768
  buffer_load_dwordx4 v[120:123], v9, s[44:47], s99 offen nt
  s_add_u32 s99, s99, 32768
  buffer_load_dwordx4 v[124:127], v9, s[44:47], s99 offen nt
  s_waitcnt vmcnt(8)
  v_perm_b32 v160, v100, v96, s48
  v_perm_b32 v164, v100, v96, s49
  v_perm_b32 v168, v101, v97, s48
  v_perm_b32 v172, v101, v97, s49
  v_perm_b32 v176, v102, v98, s48
  v_perm_b32 v180, v102, v98, s49
  v_perm_b32 v184, v103, v99, s48
  v_perm_b32 v188, v103, v99, s49
  s_waitcnt vmcnt(6)
  v_perm_b32 v161, v108, v104, s48
  v_perm_b32 v165, v108, v104, s49
  v_perm_b32 v169, v109, v105, s48
  v_perm_b32 v173, v109, v105, s49
  v_perm_b32 v177, v110, v106, s48
  v_perm_b32 v181, v110, v106, s49
  v_perm_b32 v185, v111, v107, s48
  v_perm_b32 v189, v111, v107, s49
  s_waitcnt vmcnt(4)
  s_branch L_aqchk
L_aqretry:
  buffer_load_dwordx4 v[16:19], v61, s[40:43], s96 offen sc1
  buffer_load_dwordx4 v[20:23], v61, s[40:43], s97 offen sc1
  s_waitcnt vmcnt(0)
L_aqchk:
  v_perm_b32 v14, v17, v16, s54
  v_perm_b32 v15, v19, v18, s55
  v_xor_b32 v12, s56, v14
  v_bitop3_b32 v12, v12, v15, s57 bitop3:0xf6
  v_perm_b32 v14, v21, v20, s54
  v_perm_b32 v15, v23, v22, s55
  v_bitop3_b32 v12, v12, v14, s56 bitop3:0xf6
  v_bitop3_b32 v12, v12, v15, s57 bitop3:0xf6
  v_cmp_ne_u32 vcc, 0, v12
  s_add_u32 s59, s59, 1
  s_cbranch_vccz L_aqok
  s_sub_u32 s61, 0, s101
  s_cmp_ge_u32 s59, 48
  s_cselect_b32 s95, s101, 0
  s_cselect_b32 s101, s61, s101
  s_add_u32 s96, s96, s95
  s_add_u32 s97, s97, s95
  s_cmp_gt_u32 s59, 16384
  s_cbranch_scc1 L_aqok
  s_sleep 1
  s_branch L_aqretry
L_aqok:
  v_and_b32 v16, s58, v16
  v_and_b32 v17, s58, v17
  v_and_b32 v18, s58, v18
  v_and_b32 v19, s58, v19
  v_and_b32 v20, s58, v20
  v_and_b32 v21, s58, v21
  v_and_b32 v22, s58, v22
  v_and_b32 v23, s58, v23
  v_add_f32 v16, v16, v20
  v_add_f32 v17, v17, v21
  v_add_f32 v18, v18, v22
  v_add_f32 v19, v19, v23
  v_mov_b32 v20, v16
  v_mov_b32 v21, v17
  v_mov_b32 v22, v18
  v_mov_b32 v23, v19
  v_permlane32_swap_b32 v16, v20
  v_permlane32_swap_b32 v17, v21
  v_permlane32_swap_b32 v18, v22
  v_permlane32_swap_b32 v19, v23
  v_add_f32 v16, v16, v20
  v_add_f32 v17, v17, v21
  v_add_f32 v18, v18, v22
  v_add_f32 v19, v19, v23
  v_cvt_pk_bf16_f32 v20, v16, v17
  v_cvt_pk_bf16_f32 v21, v18, v19
  ds_write_b64 v62, v[20:21] offset:2048
  v_mov_b32 v10, 0
  s_mov_b64 exec, 1
  ds_add_u32 v10, v59 offset:12480
  s_mov_b64 exec, -1
  v_mov_b32 v10, 0
  s_mov_b32 s59, 0
L_await_q:
  ds_read_b32 v12, v10 offset:12480
  ds_read_b128 v[16:19], v60 offset:2048
  ds_read_b128 v[20:23], v60 offset:2112
  ds_read_b128 v[24:27], v60 offset:2176
  ds_read_b128 v[28:31], v60 offset:2240
  s_add_u32 s59, s59, 1
  s_waitcnt lgkmcnt(0)
  v_readfirstlane_b32 s60, v12
  s_cmp_gt_u32 s59, 262144
  s_cbranch_scc1 L_await_q_x
  s_cmp_lt_u32 s60, 4
  s_cbranch_scc1 L_await_q
L_await_q_x:
  v_mfma_f32_16x16x32_bf16 v[32:35], v[64:67], v[16:19], 0
  v_mfma_f32_16x16x32_bf16 v[36:39], v[80:83], v[16:19], 0
  v_mfma_f32_16x16x32_bf16 v[32:35], v[68:71], v[20:23], v[32:35]
  v_mfma_f32_16x16x32_bf16 v[36:39], v[84:87], v[20:23], v[36:39]
  v_mfma_f32_16x16x32_bf16 v[32:35], v[72:75], v[24:27], v[32:35]
  v_mfma_f32_16x16x32_bf16 v[36:39], v[88:91], v[24:27], v[36:39]
  v_mfma_f32_16x16x32_bf16 v[32:35], v[76:79], v[28:31], v[32:35]
  v_mfma_f32_16x16x32_bf16 v[36:39], v[92:95], v[28:31], v[36:39]
  s_mov_b32 s60, 0x3db504f3
  s_nop 5
  v_cvt_pk_bf16_f32 v40, v32, v33
  v_cvt_pk_bf16_f32 v41, v34, v35
  v_cvt_pk_bf16_f32 v42, v36, v37
  v_cvt_pk_bf16_f32 v43, v38, v39
  v_lshlrev_b32 v32, 16, v40
  v_and_b32 v33, 0xffff0000, v40
  v_lshlrev_b32 v34, 16, v41
  v_and_b32 v35, 0xffff0000, v41
  v_lshlrev_b32 v36, 16, v42
  v_and_b32 v37, 0xffff0000, v42
  v_lshlrev_b32 v38, 16, v43
  v_and_b32 v39, 0xffff0000, v43
  v_mul_f32 v32, s60, v32
  v_mul_f32 v33, s60, v33
  v_mul_f32 v34, s60, v34
  v_mul_f32 v35, s60, v35
  v_mul_f32 v36, s60, v36
  v_mul_f32 v37, s60, v37
  v_mul_f32 v38, s60, v38
  v_mul_f32 v39, s60, v39
  v_cvt_pk_bf16_f32 v40, v32, v33
  v_cvt_pk_bf16_f32 v41, v34, v35
  v_cvt_pk_bf16_f32 v42, v36, v37
  v_cvt_pk_bf16_f32 v43, v38, v39
  v_lshlrev_b32 v32, 16, v40
  v_and_b32 v33, 0xffff0000, v40
  v_lshlrev_b32 v34, 16, v41
  v_and_b32 v35, 0xffff0000, v41
  v_lshlrev_b32 v36, 16, v42
  v_and_b32 v37, 0xffff0000, v42
  v_lshlrev_b32 v38, 16, v43
  v_and_b32 v39, 0xffff0000, v43
  v_max3_f32 v44, v32, v33, v34
  v_max3_f32 v45, v35, v36, v37
  v_max3_f32 v44, v44, v38, v39
  v_max_f32 v44, v44, v45
  v_mov_b32 v45, v44
  s_nop 1
  v_permlane16_swap_b32 v44, v45
  v_max_f32 v44, v44, v45
  v_mov_b32 v45, v44
  s_nop 1
  v_permlane32_swap_b32 v44, v45
  v_max_f32 v44, v44, v45
  s_mov_b32 s60, 0x3fb8aa3b
  v_mul_f32 v46, s60, v44
  v_fma_f32 v32, v32, s60, -v46
  v_fma_f32 v33, v33, s60, -v46
  v_fma_f32 v34, v34, s60, -v46
  v_fma_f32 v35, v35, s60, -v46
  v_fma_f32 v36, v36, s60, -v46
  v_fma_f32 v37, v37, s60, -v46
  v_fma_f32 v38, v38, s60, -v46
  v_fma_f32 v39, v39, s60, -v46
  v_exp_f32 v32, v32
  v_exp_f32 v33, v33
  v_exp_f32 v34, v34
  v_exp_f32 v35, v35
  v_exp_f32 v36, v36
  v_exp_f32 v37, v37
  v_exp_f32 v38, v38
  v_exp_f32 v39, v39
  v_cvt_pk_bf16_f32 v40, v32, v33
  v_cvt_pk_bf16_f32 v41, v34, v35
  v_cvt_pk_bf16_f32 v42, v36, v37
  v_cvt_pk_bf16_f32 v43, v38, v39
  v_add_f32 v45, v32, v33
  v_add_f32 v46, v34, v35
  v_add_f32 v47, v36, v37
  v_add_f32 v48, v38, v39
  v_add_f32 v45, v45, v46
  v_add_f32 v47, v47, v48
  v_add_f32 v45, v45, v47
  v_mov_b32 v46, v45
  s_nop 1
  v_permlane16_swap_b32 v45, v46
  v_add_f32 v45, v45, v46
  v_mov_b32 v46, v45
  s_nop 1
  v_permlane32_swap_b32 v45, v46
  v_add_f32 v45, v45, v46
  s_waitcnt vmcnt(2)
  v_perm_b32 v162, v116, v112, s48
  v_perm_b32 v166, v116, v112, s49
  v_perm_b32 v170, v117, v113, s48
  v_perm_b32 v174, v117, v113, s49
  v_perm_b32 v178, v118, v114, s48
  v_perm_b32 v182, v118, v114, s49
  v_perm_b32 v186, v119, v115, s48
  v_perm_b32 v190, v119, v115, s49
  s_waitcnt vmcnt(0)
  v_perm_b32 v163, v124, v120, s48
  v_perm_b32 v167, v124, v120, s49
  v_perm_b32 v171, v125, v121, s48
  v_perm_b32 v175, v125, v121, s49
  v_perm_b32 v179, v126, v122, s48
  v_perm_b32 v183, v126, v122, s49
  v_perm_b32 v187, v127, v123, s48
  v_perm_b32 v191, v127, v123, s49
  v_mfma_f32_16x16x32_bf16 v[128:131], v[40:43], v[160:163], 0
  v_mfma_f32_16x16x32_bf16 v[132:135], v[40:43], v[164:167], 0
  v_mfma_f32_16x16x32_bf16 v[136:139], v[40:43], v[168:171], 0
  v_mfma_f32_16x16x32_bf16 v[140:143], v[40:43], v[172:175], 0
  v_mfma_f32_16x16x32_bf16 v[144:147], v[40:43], v[176:179], 0
  v_mfma_f32_16x16x32_bf16 v[148:151], v[40:43], v[180:183], 0
  v_mfma_f32_16x16x32_bf16 v[152:155], v[40:43], v[184:187], 0
  v_mfma_f32_16x16x32_bf16 v[156:159], v[40:43], v[188:191], 0
  s_nop 0
  v_mov_b32 v16, v128
  v_mov_b32 v17, v132
  v_mov_b32 v18, v136
  v_mov_b32 v19, v140
  v_mov_b32 v20, v144
  v_mov_b32 v21, v148
  v_mov_b32 v22, v152
  v_mov_b32 v23, v156
  ds_write_b128 v54, v[16:19] offset:4096
  ds_write_b128 v54, v[20:23] offset:4112
  s_mov_b32 exec_lo, 0x1111
  s_mov_b32 exec_hi, 0
  ds_write_b64 v55, v[44:45] offset:12288
  s_mov_b64 exec, 1
  ds_add_u32 v10, v59 offset:12432
  s_mov_b64 exec, -1
  v_mov_b32 v10, 0
  s_mov_b32 s59, 0
  v_mov_b32 v42, 0
L_await_a:
  ds_read_b32 v12, v10 offset:12432
  ds_read_b128 v[16:19], v56 offset:4096
  ds_read_b128 v[20:23], v56 offset:6144
  ds_read_b128 v[24:27], v56 offset:8192
  ds_read_b128 v[28:31], v56 offset:10240
  ds_read_b128 v[32:35], v57 offset:12288
  ds_read_b128 v[36:39], v57 offset:12304
  s_add_u32 s59, s59, 1
  s_waitcnt lgkmcnt(0)
  v_readfirstlane_b32 s60, v12
  s_cmp_gt_u32 s59, 262144
  s_cbranch_scc1 L_await_a_x
  s_cmp_lt_u32 s60, 4
  s_cbranch_scc1 L_await_a
L_await_a_x:
  s_mov_b32 s60, 0x3fb8aa3b
  v_max3_f32 v40, v32, v34, v36
  v_max_f32 v40, v40, v38
  v_sub_f32 v32, v32, v40
  v_sub_f32 v34, v34, v40
  v_sub_f32 v36, v36, v40
  v_sub_f32 v38, v38, v40
  v_mul_f32 v32, s60, v32
  v_mul_f32 v34, s60, v34
  v_mul_f32 v36, s60, v36
  v_mul_f32 v38, s60, v38
  v_exp_f32 v32, v32
  v_exp_f32 v34, v34
  v_exp_f32 v36, v36
  v_exp_f32 v38, v38
  v_mul_f32 v44, v32, v16
  v_mul_f32 v45, v32, v17
  v_mul_f32 v46, v32, v18
  v_mul_f32 v47, v32, v19
  v_mul_f32 v41, v32, v33
  v_fmac_f32 v44, v34, v20
  v_fmac_f32 v45, v34, v21
  v_fmac_f32 v46, v34, v22
  v_fmac_f32 v47, v34, v23
  v_fmac_f32 v41, v34, v35
  v_fmac_f32 v44, v36, v24
  v_fmac_f32 v45, v36, v25
  v_fmac_f32 v46, v36, v26
  v_fmac_f32 v47, v36, v27
  v_fmac_f32 v41, v36, v37
  v_fmac_f32 v44, v38, v28
  v_fmac_f32 v45, v38, v29
  v_fmac_f32 v46, v38, v30
  v_fmac_f32 v47, v38, v31
  v_fmac_f32 v41, v38, v39
  v_cndmask_b32 v44, v44, v40, s[62:63]
  v_cndmask_b32 v45, v45, v41, s[62:63]
  v_cndmask_b32 v46, v46, v42, s[62:63]
  v_cndmask_b32 v47, v47, v42, s[62:63]
  v_perm_b32 v44, v44, v254, s50
  v_perm_b32 v45, v45, v254, s51
  v_perm_b32 v46, v46, v254, s52
  v_perm_b32 v47, v47, v254, s53
  s_mov_b32 exec_lo, -1
  s_mov_b32 exec_hi, 1
  buffer_store_dwordx4 v[44:47], v52, s[40:43], 0 offen
  s_mov_b64 exec, 1
  ds_add_u32 v10, v59 offset:12448
  s_mov_b64 exec, -1
  v_mov_b32 v10, 0
  s_mov_b32 s59, 0
L_await_col:
  ds_read_b32 v12, v10 offset:12416
  s_add_u32 s59, s59, 1
  s_waitcnt lgkmcnt(0)
  v_readfirstlane_b32 s60, v12
  s_cmp_gt_u32 s59, 262144
  s_cbranch_scc1 L_await_col_x
  s_cmp_lt_u32 s60, 1
  s_cbranch_scc1 L_await_col
L_await_col_x:
  s_cmp_eq_u32 s60, 1
  s_cbranch_scc1 L_end
  s_mov_b32 s60, 786432
  s_mov_b32 exec_lo, -1
  s_mov_b32 exec_hi, 1
  buffer_store_dwordx4 v[44:47], v52, s[40:43], s60 offen sc1
  s_mov_b64 exec, -1
  s_branch L_end
L_roleO2:
  v_lshrrev_b32 v2, 4, v0
  v_and_b32 v3, 15, v0
  s_mov_b32 s48, 0x05040100
  s_mov_b32 s49, 0x07060302
  s_mov_b32 s50, 0x07060500
  s_mov_b32 s51, 0x07060501
  s_mov_b32 s52, 0x07060502
  s_mov_b32 s53, 0x07060503
  s_mov_b32 s54, 0x0c0c0400
  s_mov_b32 s55, 0x04000c0c
  s_mov_b32 s58, 0xffffff00
  s_sub_u32 s3, s3, 2
  s_lshr_b32 s96, s5, 2
  s_and_b32 s97, s5, 3
  s_lshl_b32 s98, s4, 19
  s_lshl_b32 s99, s96, 16
  s_add_u32 s98, s98, s99
  s_lshl_b32 s99, s3, 15
  s_add_u32 s98, s98, s99
  s_lshl_b32 s99, s97, 8
  s_add_u32 s98, s98, s99
  s_add_u32 s99, s98, 4096
  v_lshlrev_b32 v8, 13, v2
  v_lshl_add_u32 v8, v3, 4, v8
  s_lshl_b32 s100, s4, 3
  s_add_u32 s100, s100, s96
  s_waitcnt lgkmcnt(0)
  s_load_dword s6, s[30:31], 0
  s_mov_b32 s40, s30
  s_and_b32 s41, s31, 0xffff
  s_mov_b32 s42, 536870912
  s_mov_b32 s43, 0x20000
  s_mov_b32 s32, s16
  s_and_b32 s33, s17, 0xffff
  s_mov_b32 s34, 4194304
  s_mov_b32 s35, 0x20000
  s_lshl_b32 s60, s4, 16
  s_lshr_b32 s61, s96, 1
  s_lshl_b32 s101, s61, 14
  s_add_u32 s60, s60, s101
  s_and_b32 s101, s96, 1
  s_lshl_b32 s101, s101, 13
  s_add_u32 s60, s60, s101
  s_lshl_b32 s101, s3, 12
  s_add_u32 s60, s60, s101
  s_add_u32 s36, s60, 262144
  s_mov_b32 s37, s36
  v_lshlrev_b32 v9, 10, v2
  v_lshl_add_u32 v9, v3, 4, v9
  s_lshl_b32 s38, s4, 2
  s_add_u32 s38, s38, s61
  s_lshl_b32 s38, s38, 9
  s_add_u32 s38, s38, 196608
  v_and_b32 v11, 31, v0
  v_lshlrev_b32 v11, 4, v11
  s_lshl_b32 s39, s100, 11
  s_lshl_b32 s61, s97, 9
  s_add_u32 s39, s39, s61
  s_add_u32 s39, s39, 1572864
  s_waitcnt lgkmcnt(0)
  s_add_u32 s7, s6, 1
  s_mul_i32 s6, s7, 0x01010101
  s_xor_b32 s6, s6, 0x5c3a96f0
  s_and_b32 s56, s6, 0xffff
  s_and_b32 s57, s6, 0xffff0000
  v_mov_b32 v254, s6
  s_barrier
  s_barrier
  s_barrier
  buffer_load_dwordx4 v[64:67], v8, s[32:35], s98 offen offset:0 nt
  buffer_load_dwordx4 v[68:71], v8, s[32:35], s98 offen offset:1024 nt
  buffer_load_dwordx4 v[72:75], v8, s[32:35], s98 offen offset:2048 nt
  buffer_load_dwordx4 v[76:79], v8, s[32:35], s98 offen offset:3072 nt
  buffer_load_dwordx4 v[80:83], v8, s[32:35], s99 offen offset:0 nt
  buffer_load_dwordx4 v[84:87], v8, s[32:35], s99 offen offset:1024 nt
  buffer_load_dwordx4 v[88:91], v8, s[32:35], s99 offen offset:2048 nt
  buffer_load_dwordx4 v[92:95], v8, s[32:35], s99 offen offset:3072 nt
  s_lshl_b32 s60, s4, 4
  s_and_b32 s61, s5, 15
  s_add_u32 s60, s60, s61
  s_lshl_b32 s60, s60, 4
  s_add_u32 s60, s60, 1572864
  v_lshlrev_b32 v210, 11, v0
  v_add_u32 v210, s60, v210
  s_lshl_b32 s60, s4, 16
  s_lshl_b32 s61, s5, 11
  s_add_u32 s60, s60, s61
  s_add_u32 s60, s60, 262144
  v_lshlrev_b32 v211, 6, v0
  v_add_u32 v211, s60, v211
  s_lshl_b32 s60, s4, 11
  s_and_b32 s61, s5, 15
  s_lshl_b32 s61, s61, 7
  s_add_u32 s60, s60, s61
  s_add_u32 s60, s60, 194560
  v_lshlrev_b32 v213, 6, v0
  v_add_u32 v213, s60, v213
  v_cmp_le_u32 vcc, 32, v0
  s_cmp_lt_u32 s2, 128
  s_cselect_b32 s60, -1, 1
  s_cselect_b32 s61, -1, 0
  v_cndmask_b32 v211, v211, v213, vcc
  s_cmp_eq_u32 s3, 0
  s_cselect_b32 s60, s60, -1
  s_cselect_b32 s61, s61, 3
  s_cselect_b64 vcc, -1, 0
  s_mov_b32 exec_lo, s60
  v_cndmask_b32 v210, v211, v210, vcc
  s_mov_b32 exec_hi, s61
  buffer_load_dword v212, v210, s[40:43], 0 offen sc1
  s_mov_b64 exec, -1
  s_waitcnt vmcnt(7)
  v_perm_b32 v96, v68, v64, s48
  v_perm_b32 v100, v68, v64, s49
  v_perm_b32 v104, v69, v65, s48
  v_perm_b32 v108, v69, v65, s49
  v_perm_b32 v112, v70, v66, s48
  v_perm_b32 v116, v70, v66, s49
  v_perm_b32 v120, v71, v67, s48
  v_perm_b32 v124, v71, v67, s49
  s_waitcnt vmcnt(5)
  v_perm_b32 v97, v76, v72, s48
  v_perm_b32 v101, v76, v72, s49
  v_perm_b32 v105, v77, v73, s48
  v_perm_b32 v109, v77, v73, s49
  v_perm_b32 v113, v78, v74, s48
  v_perm_b32 v117, v78, v74, s49
  v_perm_b32 v121, v79, v75, s48
  v_perm_b32 v125, v79, v75, s49
  s_waitcnt vmcnt(3)
  v_perm_b32 v98, v84, v80, s48
  v_perm_b32 v102, v84, v80, s49
  v_perm_b32 v106, v85, v81, s48
  v_perm_b32 v110, v85, v81, s49
  v_perm_b32 v114, v86, v82, s48
  v_perm_b32 v118, v86, v82, s49
  v_perm_b32 v122, v87, v83, s48
  v_perm_b32 v126, v87, v83, s49
  s_waitcnt vmcnt(1)
  v_perm_b32 v99, v92, v88, s48
  v_perm_b32 v103, v92, v88, s49
  v_perm_b32 v107, v93, v89, s48
  v_perm_b32 v111, v93, v89, s49
  v_perm_b32 v115, v94, v90, s48
  v_perm_b32 v119, v94, v90, s49
  v_perm_b32 v123, v95, v91, s48
  v_perm_b32 v127, v95, v91, s49
  v_mov_b32 v10, 0
  s_mov_b32 s59, 0
L_await_pub:
  ds_read_b32 v12, v10 offset:12448
  s_add_u32 s59, s59, 1
  s_waitcnt lgkmcnt(0)
  v_readfirstlane_b32 s60, v12
  s_cmp_gt_u32 s59, 262144
  s_cbranch_scc1 L_await_pub_x
  s_cmp_lt_u32 s60, 4
  s_cbranch_scc1 L_await_pub
L_await_pub_x:
  v_and_b32 v12, 16, v0
  v_cmp_ne_u32 s[62:63], 0, v12
  v_lshlrev_b32 v13, 5, v3
  v_lshl_add_u32 v13, v2, 4, v13
  s_mov_b32 s59, 0
  s_mov_b32 s101, 786432
L_mlpoll:
  buffer_load_dwordx4 v[32:35], v11, s[40:43], s38 offen sc1
  s_waitcnt vmcnt(0)
  v_perm_b32 v14, v33, v32, s54
  v_perm_b32 v15, v35, v34, s55
  v_xor_b32 v12, s56, v14
  v_bitop3_b32 v12, v12, v15, s57 bitop3:0xf6
  v_cmp_ne_u32 vcc, 0, v12
  s_add_u32 s59, s59, 1
  s_cbranch_vccz L_mlok
  s_sub_u32 s61, 0, s101
  s_cmp_ge_u32 s59, 48
  s_cselect_b32 s95, s101, 0
  s_cselect_b32 s101, s61, s101
  s_add_u32 s36, s36, s95
  s_add_u32 s37, s37, s95
  s_add_u32 s38, s38, s95
  s_cmp_gt_u32 s59, 16384
  s_cbranch_scc1 L_mlok
  s_sleep 1
  s_branch L_mlpoll
L_mlok:
  buffer_load_dwordx4 v[16:19], v9, s[40:43], s36 offen sc1
  buffer_load_dwordx4 v[20:23], v9, s[40:43], s36 offen offset:512 sc1
  buffer_load_dwordx4 v[24:27], v9, s[40:43], s36 offen offset:256 sc1
  buffer_load_dwordx4 v[28:31], v9, s[40:43], s36 offen offset:768 sc1
  v_and_b32 v32, s58, v32
  v_and_b32 v33, s58, v33
  v_mov_b32 v44, v32
  s_nop 1
  v_max_f32_dpp v44, v44, v44 row_ror:8 row_mask:0xf bank_mask:0xf
  s_nop 1
  v_max_f32_dpp v44, v44, v44 row_ror:4 row_mask:0xf bank_mask:0xf
  s_nop 1
  v_max_f32_dpp v44, v44, v44 row_ror:2 row_mask:0xf bank_mask:0xf
  s_nop 1
  v_max_f32_dpp v44, v44, v44 row_ror:1 row_mask:0xf bank_mask:0xf
  v_mov_b32 v45, v44
  s_nop 1
  v_permlane16_swap_b32 v44, v45
  v_max_f32 v44, v44, v45
  s_mov_b32 s60, 0x3fb8aa3b
  v_sub_f32 v32, v32, v44
  v_mul_f32 v32, s60, v32
  v_exp_f32 v32, v32
  s_nop 0
  v_mul_f32 v45, v32, v33
  s_nop 1
  v_add_f32_dpp v45, v45, v45 row_ror:8 row_mask:0xf bank_mask:0xf
  s_nop 1
  v_add_f32_dpp v45, v45, v45 row_ror:4 row_mask:0xf bank_mask:0xf
  s_nop 1
  v_add_f32_dpp v45, v45, v45 row_ror:2 row_mask:0xf bank_mask:0xf
  s_nop 1
  v_add_f32_dpp v45, v45, v45 row_ror:1 row_mask:0xf bank_mask:0xf
  v_mov_b32 v46, v45
  v_mov_b32 v36, v32
  s_nop 0
  v_permlane16_swap_b32 v45, v46
  v_permlane16_swap_b32 v32, v36
  v_add_f32 v45, v45, v46
  v_rcp_f32 v45, v45
  s_mov_b32 s59, 0
  s_nop 0
  v_mul_f32 v32, v32, v45
  v_mul_f32 v36, v36, v45
L_apchk:
  s_waitcnt vmcnt(0)
  v_perm_b32 v14, v17, v16, s54
  v_perm_b32 v15, v19, v18, s55
  v_xor_b32 v12, s56, v14
  v_bitop3_b32 v12, v12, v15, s57 bitop3:0xf6
  v_perm_b32 v14, v21, v20, s54
  v_perm_b32 v15, v23, v22, s55
  v_bitop3_b32 v12, v12, v14, s56 bitop3:0xf6
  v_bitop3_b32 v12, v12, v15, s57 bitop3:0xf6
  v_perm_b32 v14, v25, v24, s54
  v_perm_b32 v15, v27, v26, s55
  v_bitop3_b32 v12, v12, v14, s56 bitop3:0xf6
  v_bitop3_b32 v12, v12, v15, s57 bitop3:0xf6
  v_perm_b32 v14, v29, v28, s54
  v_perm_b32 v15, v31, v30, s55
  v_bitop3_b32 v12, v12, v14, s56 bitop3:0xf6
  v_bitop3_b32 v12, v12, v15, s57 bitop3:0xf6
  v_cmp_ne_u32 vcc, 0, v12
  s_add_u32 s59, s59, 1
  s_cbranch_vccz L_ook
  s_sub_u32 s61, 0, s101
  s_cmp_ge_u32 s59, 48
  s_cselect_b32 s95, s101, 0
  s_cselect_b32 s101, s61, s101
  s_add_u32 s36, s36, s95
  s_cmp_gt_u32 s59, 16384
  s_cbranch_scc1 L_ook
  buffer_load_dwordx4 v[16:19], v9, s[40:43], s36 offen sc1
  buffer_load_dwordx4 v[20:23], v9, s[40:43], s36 offen offset:512 sc1
  buffer_load_dwordx4 v[24:27], v9, s[40:43], s36 offen offset:256 sc1
  buffer_load_dwordx4 v[28:31], v9, s[40:43], s36 offen offset:768 sc1
  s_branch L_apchk
L_ook:
  v_and_b32 v16, s58, v16
  v_and_b32 v17, s58, v17
  v_and_b32 v18, s58, v18
  v_and_b32 v19, s58, v19
  v_and_b32 v20, s58, v20
  v_and_b32 v21, s58, v21
  v_and_b32 v22, s58, v22
  v_and_b32 v23, s58, v23
  v_and_b32 v24, s58, v24
  v_and_b32 v25, s58, v25
  v_and_b32 v26, s58, v26
  v_and_b32 v27, s58, v27
  v_and_b32 v28, s58, v28
  v_and_b32 v29, s58, v29
  v_and_b32 v30, s58, v30
  v_and_b32 v31, s58, v31
  v_mul_f32 v16, v32, v16
  v_mul_f32 v17, v32, v17
  v_mul_f32 v18, v32, v18
  v_mul_f32 v19, v32, v19
  v_mul_f32 v20, v32, v20
  v_mul_f32 v21, v32, v21
  v_mul_f32 v22, v32, v22
  v_mul_f32 v23, v32, v23
  v_fmac_f32 v16, v36, v24
  v_fmac_f32 v17, v36, v25
  v_fmac_f32 v18, v36, v26
  v_fmac_f32 v19, v36, v27
  v_fmac_f32 v20, v36, v28
  v_fmac_f32 v21, v36, v29
  v_fmac_f32 v22, v36, v30
  v_fmac_f32 v23, v36, v31
  v_add_f32_dpp v16, v16, v16 row_ror:8 row_mask:0xf bank_mask:0xf
  v_add_f32_dpp v17, v17, v17 row_ror:8 row_mask:0xf bank_mask:0xf
  v_add_f32_dpp v18, v18, v18 row_ror:8 row_mask:0xf bank_mask:0xf
  v_add_f32_dpp v19, v19, v19 row_ror:8 row_mask:0xf bank_mask:0xf
  v_add_f32_dpp v20, v20, v20 row_ror:8 row_mask:0xf bank_mask:0xf
  v_add_f32_dpp v21, v21, v21 row_ror:8 row_mask:0xf bank_mask:0xf
  v_add_f32_dpp v22, v22, v22 row_ror:8 row_mask:0xf bank_mask:0xf
  v_add_f32_dpp v23, v23, v23 row_ror:8 row_mask:0xf bank_mask:0xf
  v_add_f32_dpp v16, v16, v16 row_ror:4 row_mask:0xf bank_mask:0xf
  v_add_f32_dpp v17, v17, v17 row_ror:4 row_mask:0xf bank_mask:0xf
  v_add_f32_dpp v18, v18, v18 row_ror:4 row_mask:0xf bank_mask:0xf
  v_add_f32_dpp v19, v19, v19 row_ror:4 row_mask:0xf bank_mask:0xf
  v_add_f32_dpp v20, v20, v20 row_ror:4 row_mask:0xf bank_mask:0xf
  v_add_f32_dpp v21, v21, v21 row_ror:4 row_mask:0xf bank_mask:0xf
  v_add_f32_dpp v22, v22, v22 row_ror:4 row_mask:0xf bank_mask:0xf
  v_add_f32_dpp v23, v23, v23 row_ror:4 row_mask:0xf bank_mask:0xf
  v_add_f32_dpp v16, v16, v16 row_ror:2 row_mask:0xf bank_mask:0xf
  v_add_f32_dpp v17, v17, v17 row_ror:2 row_mask:0xf bank_mask:0xf
  v_add_f32_dpp v18, v18, v18 row_ror:2 row_mask:0xf bank_mask:0xf
  v_add_f32_dpp v19, v19, v19 row_ror:2 row_mask:0xf bank_mask:0xf
  v_add_f32_dpp v20, v20, v20 row_ror:2 row_mask:0xf bank_mask:0xf
  v_add_f32_dpp v21, v21, v21 row_ror:2 row_mask:0xf bank_mask:0xf
  v_add_f32_dpp v22, v22, v22 row_ror:2 row_mask:0xf bank_mask:0xf
  v_add_f32_dpp v23, v23, v23 row_ror:2 row_mask:0xf bank_mask:0xf
  v_add_f32_dpp v16, v16, v16 row_ror:1 row_mask:0xf bank_mask:0xf
  v_add_f32_dpp v17, v17, v17 row_ror:1 row_mask:0xf bank_mask:0xf
  v_add_f32_dpp v18, v18, v18 row_ror:1 row_mask:0xf bank_mask:0xf
  v_add_f32_dpp v19, v19, v19 row_ror:1 row_mask:0xf bank_mask:0xf
  v_add_f32_dpp v20, v20, v20 row_ror:1 row_mask:0xf bank_mask:0xf
  v_add_f32_dpp v21, v21, v21 row_ror:1 row_mask:0xf bank_mask:0xf
  v_add_f32_dpp v22, v22, v22 row_ror:1 row_mask:0xf bank_mask:0xf
  v_add_f32_dpp v23, v23, v23 row_ror:1 row_mask:0xf bank_mask:0xf
  v_cvt_pk_bf16_f32 v24, v16, v17
  v_cvt_pk_bf16_f32 v25, v18, v19
  v_cvt_pk_bf16_f32 v26, v20, v21
  v_cvt_pk_bf16_f32 v27, v22, v23
  s_nop 1
  v_mfma_f32_16x16x32_bf16 v[128:131], v[24:27], v[96:99], 0
  v_mfma_f32_16x16x32_bf16 v[132:135], v[24:27], v[100:103], 0
  v_mfma_f32_16x16x32_bf16 v[136:139], v[24:27], v[104:107], 0
  v_mfma_f32_16x16x32_bf16 v[140:143], v[24:27], v[108:111], 0
  v_mfma_f32_16x16x32_bf16 v[144:147], v[24:27], v[112:115], 0
  v_mfma_f32_16x16x32_bf16 v[148:151], v[24:27], v[116:119], 0
  v_mfma_f32_16x16x32_bf16 v[152:155], v[24:27], v[120:123], 0
  v_mfma_f32_16x16x32_bf16 v[156:159], v[24:27], v[124:127], 0
  s_cmp_eq_u32 s3, 0
  s_cbranch_scc1 L_o0
  s_nop 2
  v_cndmask_b32 v16, v128, v144, s[62:63]
  v_cndmask_b32 v17, v132, v148, s[62:63]
  v_cndmask_b32 v18, v136, v152, s[62:63]
  v_cndmask_b32 v19, v140, v156, s[62:63]
  v_lshlrev_b32 v20, 4, v0
  v_mov_b32 v21, 0
  v_mov_b32 v22, 1
  s_mov_b32 exec_lo, -1
  s_mov_b32 exec_hi, 0
  ds_write_b128 v20, v[16:19] offset:12544
  s_mov_b64 exec, 1
  ds_add_u32 v21, v22 offset:12472
  s_mov_b64 exec, -1
  s_branch L_end
L_o0:
  s_nop 5
  v_cndmask_b32 v16, v128, v144, s[62:63]
  v_cndmask_b32 v17, v132, v148, s[62:63]
  v_cndmask_b32 v18, v136, v152, s[62:63]
  v_cndmask_b32 v19, v140, v156, s[62:63]
  s_cmp_lt_u32 s4, 4
  s_cselect_b32 s60, 32, 24
  s_cmp_lt_u32 s5, s60
  s_cselect_b32 s98, 1, 0
  v_mov_b32 v10, 0
  v_lshlrev_b32 v20, 4, v0
  s_mov_b32 s59, 0
L_await_rows:
  ds_read_b32 v22, v10 offset:12472
  ds_read_b128 v[24:27], v20 offset:12544
  ds_read_b128 v[28:31], v20 offset:13056
  s_add_u32 s59, s59, 1
  s_waitcnt lgkmcnt(0)
  v_readfirstlane_b32 s60, v22
  s_cmp_gt_u32 s59, 262144
  s_cbranch_scc1 L_rows_x
  s_cmp_le_u32 s60, s98
  s_cbranch_scc1 L_await_rows
L_rows_x:
  v_add_f32 v16, v16, v24
  v_add_f32 v17, v17, v25
  v_add_f32 v18, v18, v26
  v_add_f32 v19, v19, v27
  s_cmp_eq_u32 s98, 0
  s_cbranch_scc1 L_nodownrow
  v_add_f32 v16, v16, v28
  v_add_f32 v17, v17, v29
  v_add_f32 v18, v18, v30
  v_add_f32 v19, v19, v31
L_nodownrow:
  v_perm_b32 v16, v16, v254, s50
  v_perm_b32 v17, v17, v254, s51
  v_perm_b32 v18, v18, v254, s52
  v_perm_b32 v19, v19, v254, s53
  s_mov_b32 exec_lo, -1
  s_mov_b32 exec_hi, 0
  buffer_store_dwordx4 v[16:19], v13, s[40:43], s39 offen sc1
  s_mov_b64 exec, -1
  s_cmp_lt_u32 s2, 128
  s_cbranch_scc0 L_end
  s_mov_b32 s44, s8
  s_and_b32 s45, s9, 0xffff
  s_mov_b32 s46, 1024
  s_mov_b32 s47, 0x20000
  s_lshl_b32 s60, s4, 4
  s_add_u32 s60, s60, s5
  s_lshl_b32 s61, s60, 3
  v_mov_b32 v13, s61
  buffer_load_dwordx2 v[28:29], v13, s[44:47], 0 offen
  s_lshl_b32 s61, s60, 4
  s_add_u32 s61, s61, 1572864
  v_lshlrev_b32 v12, 11, v0
  s_mov_b32 s59, 0
  buffer_load_dwordx4 v[16:19], v12, s[40:43], s61 offen sc1
  s_mov_b32 s32, s26
  s_and_b32 s33, s27, 0xffff
  s_mov_b32 s34, 1024
  s_mov_b32 s35, 0x20000
L_fpoll:
  buffer_load_dwordx4 v[20:23], v12, s[40:43], s61 offen sc1
  s_waitcnt vmcnt(1)
  v_perm_b32 v30, v17, v16, s54
  v_perm_b32 v31, v19, v18, s55
  v_xor_b32 v14, s56, v30
  v_bitop3_b32 v14, v14, v31, s57 bitop3:0xf6
  v_cmp_ne_u32 vcc, 0, v14
  s_add_u32 s59, s59, 1
  s_cbranch_vccz L_fok
  buffer_load_dwordx4 v[16:19], v12, s[40:43], s61 offen sc1
  s_waitcnt vmcnt(1)
  v_perm_b32 v30, v21, v20, s54
  v_perm_b32 v31, v23, v22, s55
  v_xor_b32 v14, s56, v30
  v_bitop3_b32 v14, v14, v31, s57 bitop3:0xf6
  v_cmp_ne_u32 vcc, 0, v14
  s_cbranch_vccz L_fok2
  s_cmp_gt_u32 s59, 16384
  s_cbranch_scc0 L_fpoll
L_fok2:
  v_and_b32 v32, s58, v20
  v_and_b32 v33, s58, v21
  v_and_b32 v34, s58, v22
  v_and_b32 v35, s58, v23
  s_branch L_fsum
L_fok:
  v_and_b32 v32, s58, v16
  v_and_b32 v33, s58, v17
  v_and_b32 v34, s58, v18
  v_and_b32 v35, s58, v19
L_fsum:
  v_add_f32_dpp v32, v32, v32 row_ror:8 row_mask:0xf bank_mask:0xf
  v_add_f32_dpp v33, v33, v33 row_ror:8 row_mask:0xf bank_mask:0xf
  v_add_f32_dpp v34, v34, v34 row_ror:8 row_mask:0xf bank_mask:0xf
  v_add_f32_dpp v35, v35, v35 row_ror:8 row_mask:0xf bank_mask:0xf
  v_add_f32_dpp v32, v32, v32 row_ror:4 row_mask:0xf bank_mask:0xf
  v_add_f32_dpp v33, v33, v33 row_ror:4 row_mask:0xf bank_mask:0xf
  v_add_f32_dpp v34, v34, v34 row_ror:4 row_mask:0xf bank_mask:0xf
  v_add_f32_dpp v35, v35, v35 row_ror:4 row_mask:0xf bank_mask:0xf
  v_add_f32_dpp v32, v32, v32 row_ror:2 row_mask:0xf bank_mask:0xf
  v_add_f32_dpp v33, v33, v33 row_ror:2 row_mask:0xf bank_mask:0xf
  v_add_f32_dpp v34, v34, v34 row_ror:2 row_mask:0xf bank_mask:0xf
  v_add_f32_dpp v35, v35, v35 row_ror:2 row_mask:0xf bank_mask:0xf
  v_add_f32_dpp v32, v32, v32 row_ror:1 row_mask:0xf bank_mask:0xf
  v_add_f32_dpp v33, v33, v33 row_ror:1 row_mask:0xf bank_mask:0xf
  v_add_f32_dpp v34, v34, v34 row_ror:1 row_mask:0xf bank_mask:0xf
  v_add_f32_dpp v35, v35, v35 row_ror:1 row_mask:0xf bank_mask:0xf
  v_add_f32_dpp v32, v32, v32 row_bcast:15 row_mask:0xa bank_mask:0xf
  v_add_f32_dpp v33, v33, v33 row_bcast:15 row_mask:0xa bank_mask:0xf
  v_add_f32_dpp v34, v34, v34 row_bcast:15 row_mask:0xa bank_mask:0xf
  v_add_f32_dpp v35, v35, v35 row_bcast:15 row_mask:0xa bank_mask:0xf
  v_add_f32_dpp v32, v32, v32 row_bcast:31 row_mask:0xc bank_mask:0xf
  v_add_f32_dpp v33, v33, v33 row_bcast:31 row_mask:0xc bank_mask:0xf
  v_add_f32_dpp v34, v34, v34 row_bcast:31 row_mask:0xc bank_mask:0xf
  v_add_f32_dpp v35, v35, v35 row_bcast:31 row_mask:0xc bank_mask:0xf
  v_lshlrev_b32 v24, 16, v28
  v_and_b32 v25, 0xffff0000, v28
  v_lshlrev_b32 v26, 16, v29
  v_and_b32 v27, 0xffff0000, v29
  v_add_f32 v32, v32, v24
  v_add_f32 v33, v33, v25
  v_add_f32 v34, v34, v26
  v_add_f32 v35, v35, v27
  v_cvt_pk_bf16_f32 v36, v32, v33
  v_cvt_pk_bf16_f32 v37, v34, v35
  s_mov_b32 exec_lo, 0
  s_mov_b32 exec_hi, 0x80000000
  buffer_store_dwordx2 v[36:37], v13, s[32:35], 0 offen
  s_cmp_eq_u32 s2, 0
  s_cbranch_scc0 L_noepoch
  v_mov_b32 v38, s7
  v_mov_b32 v39, 0
  buffer_store_dword v38, v39, s[40:43], 0 offen sc1
L_noepoch:
  s_mov_b64 exec, -1
L_end:
L_exit:
  s_endpgm
.section .rodata,"a"
.p2align 6
.amdhsa_kernel parallel_sum__sliding_block_cached__glu_gated_geglu__decode_kernel
  .amdhsa_next_free_vgpr 256
  .amdhsa_next_free_sgpr 102
  .amdhsa_accum_offset 256
  .amdhsa_group_segment_fixed_size 0
  .amdhsa_kernarg_size 96
  .amdhsa_user_sgpr_count 2
  .amdhsa_user_sgpr_kernarg_segment_ptr 1
  .amdhsa_system_sgpr_workgroup_id_x 1
  .amdhsa_float_denorm_mode_32 3
.end_amdhsa_kernel
```
